```python
import torch

def _softmax(x, axis=-1):
    return torch.softmax(x, dim=axis)
def _gelu(x):
    return torch.nn.functional.gelu(x, approximate="tanh")
def _silu(x):
    return torch.nn.functional.silu(x)
def _sigmoid(x):
    return torch.sigmoid(x)
def _layernorm(x, axis=-1, eps=1e-5):
    m = x.mean(dim=axis, keepdim=True)
    v = x.var(dim=axis, keepdim=True, unbiased=False)
    return (x - m) / torch.sqrt(v + eps)
def _scatter_add(tgt, idx, src, axis=0):
    return tgt.clone().index_add_(axis, idx, src)
def _segment_sum(src, seg, n):
    out = torch.zeros((n,) + src.shape[1:], dtype=src.dtype)
    return out.index_add_(0, seg, src)
def _pad(x, pw):
    flat = tuple(v for pair in reversed(pw) for v in pair)
    return torch.nn.functional.pad(x, flat)

kernel_name = 'standalone__groupnorm__sampling'

def setup_inputs():

    _w = (lambda a: (lambda t: t.to(torch.bfloat16) if t.is_floating_point() else t)(torch.as_tensor(a)))
    B = 32
    G = 32
    cpg = max(1, 512 // G)
    C = G * cpg
    H, W = 32, 16
    return {
        "x": _w(abs((lambda *s: torch.randn(*s, dtype=torch.bfloat16) * 0.05)(B, C, H, W))),
        "g": _w((lambda *s: torch.randn(*s, dtype=torch.bfloat16) * 0.05)(C) + 1.0),
        "b": _w((lambda *s: torch.randn(*s, dtype=torch.bfloat16) * 0.4)(C)),
    }

def reference(x, g, b):
    G = 32
    B, C, H, W = x.shape[0], x.shape[1], x.shape[2], x.shape[3]
    xr = x.reshape(B, G, C // G, H, W)
    mu = xr.mean(axis=(2, 3, 4), keepdims=True)
    var = ((xr - mu) ** 2).mean(axis=(2, 3, 4), keepdims=True)
    xn = (xr - mu) / torch.sqrt(var + 1e-5)
    xn = xn.reshape(B, C, H, W)
    return xn * g[None, :, None, None] + b[None, :, None, None]
```

```asm
; @launch grid=(1024,1,1) block=(128,1,1) lds=1024
.amdgcn_target "amdgcn-amd-amdhsa--gfx950"
.text
.globl standalone__groupnorm__sampling_kernel
.p2align 8
.type standalone__groupnorm__sampling_kernel,@function
standalone__groupnorm__sampling_kernel:
    s_load_dwordx8 s[4:11], s[0:1], 0
    s_lshr_b32 s3, s2, 10
    s_cbranch_scc1 L_end
    v_readfirstlane_b32 s12, v0
    s_lshl_b32 s3, s2, 14
    s_mul_i32 s20, s12, 112
    s_add_u32 s3, s3, s20
    s_addk_i32 s3, 0x1000
    v_lshl_add_u32 v1, v0, 4, s3
    s_waitcnt lgkmcnt(0)
    global_load_dwordx4 v[8:11], v1, s[4:5] offset:-4096 nt
    global_load_dwordx4 v[12:15], v1, s[4:5] offset:-3072 nt
    global_load_dwordx4 v[16:19], v1, s[4:5] offset:-2048 nt
    global_load_dwordx4 v[20:23], v1, s[4:5] offset:-1024 nt
    global_load_dwordx4 v[24:27], v1, s[4:5] offset:0 nt
    global_load_dwordx4 v[28:31], v1, s[4:5] offset:1024 nt
    global_load_dwordx4 v[32:35], v1, s[4:5] offset:2048 nt
    global_load_dwordx4 v[36:39], v1, s[4:5] offset:3072 nt
    s_and_b32 s13, s2, 31
    s_lshl_b32 s13, s13, 5
    s_lshr_b32 s12, s12, 2
    s_add_u32 s13, s13, s12
    s_load_dwordx4 s[28:31], s[6:7], s13
    s_load_dwordx4 s[36:39], s[8:9], s13
    v_mov_b32 v2, 0x00003f80
    v_mov_b32 v3, 1.0
    v_lshlrev_b32 v4, 2, v0
    v_mov_b32 v5, 252
    s_mov_b32 s16, 0x39800000
    s_waitcnt vmcnt(7)
    v_readfirstlane_b32 s14, v8
    s_lshl_b32 s14, s14, 16
    s_xor_b32 s15, s14, 0x80000000
    v_dot2_f32_bf16 v40, v8, v2, s15
    v_dot2_f32_bf16 v41, v8, v3, s15
    v_dot2_f32_bf16 v42, v9, v2, s15
    v_dot2_f32_bf16 v43, v9, v3, s15
    v_dot2_f32_bf16 v44, v10, v2, s15
    v_dot2_f32_bf16 v45, v10, v3, s15
    v_dot2_f32_bf16 v46, v11, v2, s15
    v_dot2_f32_bf16 v47, v11, v3, s15
    v_pk_mul_f32 v[106:107], v[40:41], v[40:41]
    v_pk_add_f32 v[104:105], v[40:41], v[42:43]
    v_pk_fma_f32 v[106:107], v[42:43], v[42:43], v[106:107]
    v_pk_add_f32 v[104:105], v[104:105], v[44:45]
    v_pk_fma_f32 v[106:107], v[44:45], v[44:45], v[106:107]
    v_pk_add_f32 v[104:105], v[104:105], v[46:47]
    v_pk_fma_f32 v[106:107], v[46:47], v[46:47], v[106:107]
    s_waitcnt vmcnt(6)
    v_dot2_f32_bf16 v48, v12, v2, s15
    v_dot2_f32_bf16 v49, v12, v3, s15
    v_dot2_f32_bf16 v50, v13, v2, s15
    v_dot2_f32_bf16 v51, v13, v3, s15
    v_dot2_f32_bf16 v52, v14, v2, s15
    v_dot2_f32_bf16 v53, v14, v3, s15
    v_dot2_f32_bf16 v54, v15, v2, s15
    v_dot2_f32_bf16 v55, v15, v3, s15
    v_pk_add_f32 v[104:105], v[104:105], v[48:49]
    v_pk_fma_f32 v[106:107], v[48:49], v[48:49], v[106:107]
    v_pk_add_f32 v[104:105], v[104:105], v[50:51]
    v_pk_fma_f32 v[106:107], v[50:51], v[50:51], v[106:107]
    v_pk_add_f32 v[104:105], v[104:105], v[52:53]
    v_pk_fma_f32 v[106:107], v[52:53], v[52:53], v[106:107]
    v_pk_add_f32 v[104:105], v[104:105], v[54:55]
    v_pk_fma_f32 v[106:107], v[54:55], v[54:55], v[106:107]
    s_waitcnt vmcnt(5)
    v_dot2_f32_bf16 v56, v16, v2, s15
    v_dot2_f32_bf16 v57, v16, v3, s15
    v_dot2_f32_bf16 v58, v17, v2, s15
    v_dot2_f32_bf16 v59, v17, v3, s15
    v_dot2_f32_bf16 v60, v18, v2, s15
    v_dot2_f32_bf16 v61, v18, v3, s15
    v_dot2_f32_bf16 v62, v19, v2, s15
    v_dot2_f32_bf16 v63, v19, v3, s15
    v_pk_add_f32 v[104:105], v[104:105], v[56:57]
    v_pk_fma_f32 v[106:107], v[56:57], v[56:57], v[106:107]
    v_pk_add_f32 v[104:105], v[104:105], v[58:59]
    v_pk_fma_f32 v[106:107], v[58:59], v[58:59], v[106:107]
    v_pk_add_f32 v[104:105], v[104:105], v[60:61]
    v_pk_fma_f32 v[106:107], v[60:61], v[60:61], v[106:107]
    v_pk_add_f32 v[104:105], v[104:105], v[62:63]
    v_pk_fma_f32 v[106:107], v[62:63], v[62:63], v[106:107]
    s_waitcnt vmcnt(4)
    v_dot2_f32_bf16 v64, v20, v2, s15
    v_dot2_f32_bf16 v65, v20, v3, s15
    v_dot2_f32_bf16 v66, v21, v2, s15
    v_dot2_f32_bf16 v67, v21, v3, s15
    v_dot2_f32_bf16 v68, v22, v2, s15
    v_dot2_f32_bf16 v69, v22, v3, s15
    v_dot2_f32_bf16 v70, v23, v2, s15
    v_dot2_f32_bf16 v71, v23, v3, s15
    v_pk_add_f32 v[104:105], v[104:105], v[64:65]
    v_pk_fma_f32 v[106:107], v[64:65], v[64:65], v[106:107]
    v_pk_add_f32 v[104:105], v[104:105], v[66:67]
    v_pk_fma_f32 v[106:107], v[66:67], v[66:67], v[106:107]
    v_pk_add_f32 v[104:105], v[104:105], v[68:69]
    v_pk_fma_f32 v[106:107], v[68:69], v[68:69], v[106:107]
    v_pk_add_f32 v[104:105], v[104:105], v[70:71]
    v_pk_fma_f32 v[106:107], v[70:71], v[70:71], v[106:107]
    s_waitcnt vmcnt(3)
    v_dot2_f32_bf16 v72, v24, v2, s15
    v_dot2_f32_bf16 v73, v24, v3, s15
    v_dot2_f32_bf16 v74, v25, v2, s15
    v_dot2_f32_bf16 v75, v25, v3, s15
    v_dot2_f32_bf16 v76, v26, v2, s15
    v_dot2_f32_bf16 v77, v26, v3, s15
    v_dot2_f32_bf16 v78, v27, v2, s15
    v_dot2_f32_bf16 v79, v27, v3, s15
    v_pk_add_f32 v[104:105], v[104:105], v[72:73]
    v_pk_fma_f32 v[106:107], v[72:73], v[72:73], v[106:107]
    v_pk_add_f32 v[104:105], v[104:105], v[74:75]
    v_pk_fma_f32 v[106:107], v[74:75], v[74:75], v[106:107]
    v_pk_add_f32 v[104:105], v[104:105], v[76:77]
    v_pk_fma_f32 v[106:107], v[76:77], v[76:77], v[106:107]
    v_pk_add_f32 v[104:105], v[104:105], v[78:79]
    v_pk_fma_f32 v[106:107], v[78:79], v[78:79], v[106:107]
    s_waitcnt vmcnt(2)
    v_dot2_f32_bf16 v80, v28, v2, s15
    v_dot2_f32_bf16 v81, v28, v3, s15
    v_dot2_f32_bf16 v82, v29, v2, s15
    v_dot2_f32_bf16 v83, v29, v3, s15
    v_dot2_f32_bf16 v84, v30, v2, s15
    v_dot2_f32_bf16 v85, v30, v3, s15
    v_dot2_f32_bf16 v86, v31, v2, s15
    v_dot2_f32_bf16 v87, v31, v3, s15
    v_pk_add_f32 v[104:105], v[104:105], v[80:81]
    v_pk_fma_f32 v[106:107], v[80:81], v[80:81], v[106:107]
    v_pk_add_f32 v[104:105], v[104:105], v[82:83]
    v_pk_fma_f32 v[106:107], v[82:83], v[82:83], v[106:107]
    v_pk_add_f32 v[104:105], v[104:105], v[84:85]
    v_pk_fma_f32 v[106:107], v[84:85], v[84:85], v[106:107]
    v_pk_add_f32 v[104:105], v[104:105], v[86:87]
    v_pk_fma_f32 v[106:107], v[86:87], v[86:87], v[106:107]
    s_waitcnt vmcnt(1)
    v_dot2_f32_bf16 v88, v32, v2, s15
    v_dot2_f32_bf16 v89, v32, v3, s15
    v_dot2_f32_bf16 v90, v33, v2, s15
    v_dot2_f32_bf16 v91, v33, v3, s15
    v_dot2_f32_bf16 v92, v34, v2, s15
    v_dot2_f32_bf16 v93, v34, v3, s15
    v_dot2_f32_bf16 v94, v35, v2, s15
    v_dot2_f32_bf16 v95, v35, v3, s15
    v_pk_add_f32 v[104:105], v[104:105], v[88:89]
    v_pk_fma_f32 v[106:107], v[88:89], v[88:89], v[106:107]
    v_pk_add_f32 v[104:105], v[104:105], v[90:91]
    v_pk_fma_f32 v[106:107], v[90:91], v[90:91], v[106:107]
    v_pk_add_f32 v[104:105], v[104:105], v[92:93]
    v_pk_fma_f32 v[106:107], v[92:93], v[92:93], v[106:107]
    v_pk_add_f32 v[104:105], v[104:105], v[94:95]
    v_pk_fma_f32 v[106:107], v[94:95], v[94:95], v[106:107]
    s_waitcnt vmcnt(0)
    v_dot2_f32_bf16 v96, v36, v2, s15
    v_dot2_f32_bf16 v97, v36, v3, s15
    v_dot2_f32_bf16 v98, v37, v2, s15
    v_dot2_f32_bf16 v99, v37, v3, s15
    v_dot2_f32_bf16 v100, v38, v2, s15
    v_dot2_f32_bf16 v101, v38, v3, s15
    v_dot2_f32_bf16 v102, v39, v2, s15
    v_dot2_f32_bf16 v103, v39, v3, s15
    v_pk_add_f32 v[104:105], v[104:105], v[96:97]
    v_pk_fma_f32 v[106:107], v[96:97], v[96:97], v[106:107]
    v_pk_add_f32 v[104:105], v[104:105], v[98:99]
    v_pk_fma_f32 v[106:107], v[98:99], v[98:99], v[106:107]
    v_pk_add_f32 v[104:105], v[104:105], v[100:101]
    v_pk_fma_f32 v[106:107], v[100:101], v[100:101], v[106:107]
    v_pk_add_f32 v[104:105], v[104:105], v[102:103]
    v_pk_fma_f32 v[106:107], v[102:103], v[102:103], v[106:107]
    v_add_f32 v108, v104, v105
    v_add_f32 v109, v106, v107
    s_nop 0
    v_add_f32_dpp v108, v108, v108 row_shr:1 row_mask:0xf bank_mask:0xf
    v_add_f32_dpp v109, v109, v109 row_shr:1 row_mask:0xf bank_mask:0xf
    s_nop 0
    v_add_f32_dpp v108, v108, v108 row_shr:2 row_mask:0xf bank_mask:0xf
    v_add_f32_dpp v109, v109, v109 row_shr:2 row_mask:0xf bank_mask:0xf
    s_nop 0
    v_add_f32_dpp v108, v108, v108 row_shr:4 row_mask:0xf bank_mask:0xf
    v_add_f32_dpp v109, v109, v109 row_shr:4 row_mask:0xf bank_mask:0xf
    s_nop 0
    v_add_f32_dpp v108, v108, v108 row_shr:8 row_mask:0xf bank_mask:0xf
    v_add_f32_dpp v109, v109, v109 row_shr:8 row_mask:0xf bank_mask:0xf
    s_nop 0
    v_add_f32_dpp v108, v108, v108 row_bcast:15 row_mask:0xa bank_mask:0xf
    v_add_f32_dpp v109, v109, v109 row_bcast:15 row_mask:0xa bank_mask:0xf
    s_nop 0
    v_add_f32_dpp v108, v108, v108 row_bcast:31 row_mask:0xc bank_mask:0xf
    v_add_f32_dpp v109, v109, v109 row_bcast:31 row_mask:0xc bank_mask:0xf
    v_mul_f32 v110, s16, v108
    v_fma_f32 v109, -v110, v108, v109
    v_add_f32 v108, s14, v110
    ds_write2st64_b32 v4, v108, v109 offset0:0 offset1:2
    s_waitcnt lgkmcnt(0)
    s_barrier
    ds_read2st64_b32 v[110:111], v5 offset0:0 offset1:1
    ds_read2st64_b32 v[112:113], v5 offset0:2 offset1:3
    s_lshl_b32 s44, s28, 16
    s_lshl_b32 s60, s36, 16
    s_and_b32 s45, s28, 0xffff0000
    s_and_b32 s61, s36, 0xffff0000
    s_lshl_b32 s46, s29, 16
    s_lshl_b32 s62, s37, 16
    s_and_b32 s47, s29, 0xffff0000
    s_and_b32 s63, s37, 0xffff0000
    s_lshl_b32 s48, s30, 16
    s_lshl_b32 s64, s38, 16
    s_and_b32 s49, s30, 0xffff0000
    s_and_b32 s65, s38, 0xffff0000
    s_lshl_b32 s50, s31, 16
    s_lshl_b32 s66, s39, 16
    s_and_b32 s51, s31, 0xffff0000
    s_and_b32 s67, s39, 0xffff0000
    s_mov_b32 s17, 0x3f000000
    s_mov_b32 s18, 0x39000000
    s_waitcnt lgkmcnt(1)
    v_add_f32 v108, v110, v111
    v_mul_f32 v108, s17, v108
    v_cvt_pk_bf16_f32 v108, 0, v108
    s_waitcnt lgkmcnt(0)
    v_pk_add_f32 v[110:111], v[110:111], v[108:109] op_sel_hi:[1,0] neg_lo:[0,1] neg_hi:[0,1]
    v_pk_mul_f32 v[112:113], v[112:113], s[16:17] op_sel_hi:[1,0]
    v_pk_fma_f32 v[112:113], v[110:111], v[110:111], v[112:113]
    v_add_f32 v109, s15, v108
    v_add_f32 v112, v112, v113
    v_mul_f32 v112, s17, v112
    v_cvt_pk_bf16_f32 v112, 0, v112
    v_add_f32 v112, 0x3727c5ac, v112
    v_cvt_pk_bf16_f32 v112, 0, v112
    v_sqrt_f32 v112, v112
    s_nop 0
    v_cvt_pk_bf16_f32 v112, 0, v112
    v_rcp_f32 v112, v112
    s_nop 0
    v_mul_f32 v114, s44, v112
    v_fma_f32 v116, -v109, v114, s60
    v_pk_fma_f32 v[40:41], v[40:41], v[114:115], v[116:117] op_sel_hi:[1,0,0]
    v_pk_fma_f32 v[42:43], v[42:43], v[114:115], v[116:117] op_sel_hi:[1,0,0]
    v_pk_fma_f32 v[44:45], v[44:45], v[114:115], v[116:117] op_sel_hi:[1,0,0]
    v_pk_fma_f32 v[46:47], v[46:47], v[114:115], v[116:117] op_sel_hi:[1,0,0]
    v_cvt_pk_bf16_f32 v8, v40, v41
    v_cvt_pk_bf16_f32 v9, v42, v43
    v_cvt_pk_bf16_f32 v10, v44, v45
    v_cvt_pk_bf16_f32 v11, v46, v47
    global_store_dwordx4 v1, v[8:11], s[10:11] offset:-4096 nt
    v_mul_f32 v118, s45, v112
    v_fma_f32 v120, -v109, v118, s61
    v_pk_fma_f32 v[48:49], v[48:49], v[118:119], v[120:121] op_sel_hi:[1,0,0]
    v_pk_fma_f32 v[50:51], v[50:51], v[118:119], v[120:121] op_sel_hi:[1,0,0]
    v_pk_fma_f32 v[52:53], v[52:53], v[118:119], v[120:121] op_sel_hi:[1,0,0]
    v_pk_fma_f32 v[54:55], v[54:55], v[118:119], v[120:121] op_sel_hi:[1,0,0]
    v_cvt_pk_bf16_f32 v12, v48, v49
    v_cvt_pk_bf16_f32 v13, v50, v51
    v_cvt_pk_bf16_f32 v14, v52, v53
    v_cvt_pk_bf16_f32 v15, v54, v55
    global_store_dwordx4 v1, v[12:15], s[10:11] offset:-3072 nt
    v_mul_f32 v114, s46, v112
    v_fma_f32 v116, -v109, v114, s62
    v_pk_fma_f32 v[56:57], v[56:57], v[114:115], v[116:117] op_sel_hi:[1,0,0]
    v_pk_fma_f32 v[58:59], v[58:59], v[114:115], v[116:117] op_sel_hi:[1,0,0]
    v_pk_fma_f32 v[60:61], v[60:61], v[114:115], v[116:117] op_sel_hi:[1,0,0]
    v_pk_fma_f32 v[62:63], v[62:63], v[114:115], v[116:117] op_sel_hi:[1,0,0]
    v_cvt_pk_bf16_f32 v16, v56, v57
    v_cvt_pk_bf16_f32 v17, v58, v59
    v_cvt_pk_bf16_f32 v18, v60, v61
    v_cvt_pk_bf16_f32 v19, v62, v63
    global_store_dwordx4 v1, v[16:19], s[10:11] offset:-2048 nt
    v_mul_f32 v118, s47, v112
    v_fma_f32 v120, -v109, v118, s63
    v_pk_fma_f32 v[64:65], v[64:65], v[118:119], v[120:121] op_sel_hi:[1,0,0]
    v_pk_fma_f32 v[66:67], v[66:67], v[118:119], v[120:121] op_sel_hi:[1,0,0]
    v_pk_fma_f32 v[68:69], v[68:69], v[118:119], v[120:121] op_sel_hi:[1,0,0]
    v_pk_fma_f32 v[70:71], v[70:71], v[118:119], v[120:121] op_sel_hi:[1,0,0]
    v_cvt_pk_bf16_f32 v20, v64, v65
    v_cvt_pk_bf16_f32 v21, v66, v67
    v_cvt_pk_bf16_f32 v22, v68, v69
    v_cvt_pk_bf16_f32 v23, v70, v71
    global_store_dwordx4 v1, v[20:23], s[10:11] offset:-1024 nt
    v_mul_f32 v114, s48, v112
    v_fma_f32 v116, -v109, v114, s64
    v_pk_fma_f32 v[72:73], v[72:73], v[114:115], v[116:117] op_sel_hi:[1,0,0]
    v_pk_fma_f32 v[74:75], v[74:75], v[114:115], v[116:117] op_sel_hi:[1,0,0]
    v_pk_fma_f32 v[76:77], v[76:77], v[114:115], v[116:117] op_sel_hi:[1,0,0]
    v_pk_fma_f32 v[78:79], v[78:79], v[114:115], v[116:117] op_sel_hi:[1,0,0]
    v_cvt_pk_bf16_f32 v24, v72, v73
    v_cvt_pk_bf16_f32 v25, v74, v75
    v_cvt_pk_bf16_f32 v26, v76, v77
    v_cvt_pk_bf16_f32 v27, v78, v79
    global_store_dwordx4 v1, v[24:27], s[10:11] offset:0 nt
    v_mul_f32 v118, s49, v112
    v_fma_f32 v120, -v109, v118, s65
    v_pk_fma_f32 v[80:81], v[80:81], v[118:119], v[120:121] op_sel_hi:[1,0,0]
    v_pk_fma_f32 v[82:83], v[82:83], v[118:119], v[120:121] op_sel_hi:[1,0,0]
    v_pk_fma_f32 v[84:85], v[84:85], v[118:119], v[120:121] op_sel_hi:[1,0,0]
    v_pk_fma_f32 v[86:87], v[86:87], v[118:119], v[120:121] op_sel_hi:[1,0,0]
    v_cvt_pk_bf16_f32 v28, v80, v81
    v_cvt_pk_bf16_f32 v29, v82, v83
    v_cvt_pk_bf16_f32 v30, v84, v85
    v_cvt_pk_bf16_f32 v31, v86, v87
    global_store_dwordx4 v1, v[28:31], s[10:11] offset:1024 nt
    v_mul_f32 v114, s50, v112
    v_fma_f32 v116, -v109, v114, s66
    v_pk_fma_f32 v[88:89], v[88:89], v[114:115], v[116:117] op_sel_hi:[1,0,0]
    v_pk_fma_f32 v[90:91], v[90:91], v[114:115], v[116:117] op_sel_hi:[1,0,0]
    v_pk_fma_f32 v[92:93], v[92:93], v[114:115], v[116:117] op_sel_hi:[1,0,0]
    v_pk_fma_f32 v[94:95], v[94:95], v[114:115], v[116:117] op_sel_hi:[1,0,0]
    v_cvt_pk_bf16_f32 v32, v88, v89
    v_cvt_pk_bf16_f32 v33, v90, v91
    v_cvt_pk_bf16_f32 v34, v92, v93
    v_cvt_pk_bf16_f32 v35, v94, v95
    global_store_dwordx4 v1, v[32:35], s[10:11] offset:2048 nt
    v_mul_f32 v118, s51, v112
    v_fma_f32 v120, -v109, v118, s67
    v_pk_fma_f32 v[96:97], v[96:97], v[118:119], v[120:121] op_sel_hi:[1,0,0]
    v_pk_fma_f32 v[98:99], v[98:99], v[118:119], v[120:121] op_sel_hi:[1,0,0]
    v_pk_fma_f32 v[100:101], v[100:101], v[118:119], v[120:121] op_sel_hi:[1,0,0]
    v_pk_fma_f32 v[102:103], v[102:103], v[118:119], v[120:121] op_sel_hi:[1,0,0]
    v_cvt_pk_bf16_f32 v36, v96, v97
    v_cvt_pk_bf16_f32 v37, v98, v99
    v_cvt_pk_bf16_f32 v38, v100, v101
    v_cvt_pk_bf16_f32 v39, v102, v103
    global_store_dwordx4 v1, v[36:39], s[10:11] offset:3072 nt
L_end:
    s_endpgm
.section .rodata,"a"
.p2align 6
.amdhsa_kernel standalone__groupnorm__sampling_kernel
  .amdhsa_next_free_vgpr 122
  .amdhsa_next_free_sgpr 80
  .amdhsa_accum_offset 124
  .amdhsa_group_segment_fixed_size 0
  .amdhsa_kernarg_size 48
  .amdhsa_user_sgpr_count 2
  .amdhsa_user_sgpr_kernarg_segment_ptr 1
  .amdhsa_system_sgpr_workgroup_id_x 1
  .amdhsa_float_denorm_mode_32 3
.end_amdhsa_kernel
```
